```python
import torch

def _softmax(x, axis=-1):
    return torch.softmax(x, dim=axis)
def _gelu(x):
    return torch.nn.functional.gelu(x, approximate="tanh")
def _silu(x):
    return torch.nn.functional.silu(x)
def _sigmoid(x):
    return torch.sigmoid(x)
def _layernorm(x, axis=-1, eps=1e-5):
    m = x.mean(dim=axis, keepdim=True)
    v = x.var(dim=axis, keepdim=True, unbiased=False)
    return (x - m) / torch.sqrt(v + eps)
def _scatter_add(tgt, idx, src, axis=0):
    return tgt.clone().index_add_(axis, idx, src)
def _segment_sum(src, seg, n):
    out = torch.zeros((n,) + src.shape[1:], dtype=src.dtype)
    return out.index_add_(0, seg, src)
def _pad(x, pw):
    flat = tuple(v for pair in reversed(pw) for v in pair)
    return torch.nn.functional.pad(x, flat)

kernel_name = 'standalone__paged_block_table_kv_radixattention__decode'

def setup_inputs():

    _w = (lambda a: (lambda t: t.to(torch.bfloat16) if t.is_floating_point() else t)(torch.as_tensor(a)))
    B, H, Hkv, Dh = 1, 16, 8, 256
    Lk = 8192
    bs = 16
    nb = max(2, Lk // bs)
    P = max(1, nb // 2)
    n_phys = P + B * (nb - P)
    shared = torch.arange(P, dtype=torch.int64)
    priv = P + torch.arange(B * (nb - P), dtype=torch.int64).reshape(B, nb - P)
    bt = torch.cat([torch.tile(shared[None, :], (B, 1)), priv], dim=1)
    ctx = nb * bs - (torch.arange(1, B + 1, dtype=torch.int64) * 2654435761) % max(1, (nb * bs - P * bs) // 2)
    return {
        "q": _w((lambda *s: torch.randn(*s, dtype=torch.bfloat16) * 0.8)(B, H, Dh)),
        "k_cache": _w((lambda *s: torch.randn(*s, dtype=torch.bfloat16) * 0.8)(n_phys, bs, Hkv, Dh)),
        "v_cache": _w((lambda *s: torch.randn(*s, dtype=torch.bfloat16) * 0.05)(n_phys, bs, Hkv, Dh)),
        "block_table": _w(bt.to(torch.int64)),
        "ctx_lens": _w(torch.as_tensor(ctx).to(torch.int64)),
    }

def reference(q, k_cache, v_cache, block_table, ctx_lens):
    B, H, Dh = q.shape
    n_phys, bs, Hkv, _ = k_cache.shape
    nb = block_table.shape[1]
    Lk = nb * bs
    rep = H // Hkv
    k = k_cache[block_table].reshape(B, Lk, Hkv, Dh)
    v = v_cache[block_table].reshape(B, Lk, Hkv, Dh)
    k = (lambda x, n, axis: torch.repeat_interleave(x, n, dim=axis))(k, rep, axis=2)
    v = (lambda x, n, axis: torch.repeat_interleave(x, n, dim=axis))(v, rep, axis=2)
    scores = torch.einsum("bhd,bkhd->bhk", q, k) * (Dh ** -0.5)
    pos = torch.arange(Lk)
    valid = pos[None, :] < ctx_lens[:, None]
    scores = torch.where(valid[:, None, :], scores, -1e9)
    p = _softmax(scores, axis=-1)
    return torch.einsum("bhk,bkhd->bhd", p, v)
```

```asm
; @launch grid=(256,1,1) block=(320,1,1) lds=8640
.amdgcn_target "amdgcn-amd-amdhsa--gfx950"
.text
.p2align 12
.globl standalone__paged_block_table_kv_radixattention__decode_kernel
.p2align 8
.type standalone__paged_block_table_kv_radixattention__decode_kernel,@function
standalone__paged_block_table_kv_radixattention__decode_kernel:
    s_load_dwordx16 s[4:19], s[0:1], 0
    s_lshr_b32 s28, s2, 3
    s_cmp_ge_u32 s28, 32
    s_cbranch_scc1 L_done
    v_lshrrev_b32 v48, 6, v0
    v_and_b32 v0, 63, v0
    v_readfirstlane_b32 s3, v48
    v_lshlrev_b32 v49, 2, v0
    v_mov_b32 v50, -1
    ds_write_b32 v49, v50
    s_and_b32 s29, s2, 7
    s_cmp_eq_u32 s3, 4
    s_cbranch_scc0 L_data
    s_cmp_ge_u32 s28, 4
    s_cbranch_scc1 L_nocode
    s_getpc_b64 s[34:35]
L_pc:
    v_lshlrev_b32 v49, 7, v0
    v_min_u32 v49, L_done-L_pc, v49
    v_add_co_u32 v52, vcc, s34, v49
    v_mov_b32 v53, s35
    s_nop 0
    v_addc_co_u32 v53, vcc, 0, v53, vcc
    global_load_dword v51, v[52:53], off
L_nocode:
    s_lshl_b32 s64, s28, 6
    s_waitcnt lgkmcnt(0)
    s_load_dword s32, s[10:11], s64
    s_barrier
    s_branch L_svc
L_data:
    s_lshl_b32 s64, s3, 5
    s_add_u32 s65, s64, s28
    s_andn2_b32 s64, s65, 3
    s_lshl_b32 s65, s65, 2
    v_and_b32 v48, 15, v0
    v_lshrrev_b32 v49, 4, v0
    v_lshlrev_b32 v50, 4, v48
    s_and_b32 s67, s28, 3
    s_lshl_b32 s67, s67, 5
    s_add_u32 s67, s67, s29
    s_lshl_b32 s67, s67, 9
    v_lshl_add_u32 v1, v49, 12, v50
    v_add_u32 v1, s67, v1
    v_lshl_add_u32 v45, s64, 14, v1
    v_lshl_add_u32 v44, v48, 7, s64
    v_add_u32 v3, s65, v49
    v_lshl_add_u32 v53, v48, 9, v3
    v_lshrrev_b32 v51, 3, v48
    v_lshl_add_u32 v51, s29, 1, v51
    v_lshl_add_u32 v51, v51, 9, v50
    v_lshlrev_b32 v52, 8, v49
    v_xor_b32 v51, v51, v52
    s_mov_b32 s22, 0x2000000
    s_mov_b32 s23, 0x20000
    v_mov_b32 v54, s22
    s_waitcnt lgkmcnt(0)
    s_load_dword s30, s[12:13], 0
    s_load_dword s32, s[10:11], s64 offset:0
    s_load_dword s33, s[10:11], s64 offset:128
    global_load_dwordx4 v[164:167], v45, s[8:9] offset:0
    v_add_u32 v45, 0x200000, v45
    global_load_dwordx4 v[164:167], v45, s[8:9] offset:0
    v_add_u32 v45, 0x200000, v45
    global_load_dwordx4 v[164:167], v45, s[8:9] offset:0
    v_add_u32 v45, 0x200000, v45
    global_load_dwordx4 v[164:167], v45, s[8:9] offset:0
    s_mov_b64 s[20:21], s[6:7]
    s_waitcnt lgkmcnt(0)
    s_cmp_gt_i32 s30, 0
    s_cselect_b32 s30, s30, 0x2000
    s_cselect_b32 s36, 0x3db8aa3b, 0
    s_sub_i32 s65, s30, s65
    global_load_dword v44, v44, s[10:11]
    s_lshl_b32 s32, s32, 16
    s_cmp_gt_i32 s65, 0
    s_cselect_b32 s32, s32, s22
    buffer_load_dwordx4 v[80:83], v1, s[20:23], s32 offen offset:0 nt
    buffer_load_dwordx4 v[84:87], v1, s[20:23], s32 offen offset:256 nt
    global_load_dwordx4 v[16:19], v51, s[4:5]
    s_barrier
    s_mov_b64 s[24:25], s[8:9]
    s_mov_b32 s26, s22
    s_mov_b32 s27, 0x20000
    v_sub_u32 v3, s30, v3
    v_mov_b32 v56, 0
    v_mov_b32 v57, 0
    v_mov_b32 v58, 0
    v_mov_b32 v59, 0
    v_mov_b32 v60, 0
    v_mov_b32 v61, 0
    v_mov_b32 v62, 0
    v_mov_b32 v63, 0
    v_mov_b32 v64, 0
    v_mov_b32 v65, 0
    v_mov_b32 v66, 0
    v_mov_b32 v67, 0
    v_mov_b32 v68, 0
    v_mov_b32 v69, 0
    v_mov_b32 v70, 0
    v_mov_b32 v71, 0
    v_mov_b32 v40, 0
    v_mov_b32 v41, 0
    v_mov_b32 v42, 0xff000000
    v_mov_b32 v2, v42
    s_lshl_b32 s66, s3, 2
    v_mov_b32 v46, s66
    s_waitcnt vmcnt(7)
    s_lshl_b32 s33, s33, 16
    s_cmp_gt_i32 s65, 512
    s_cselect_b32 s33, s33, s22
    buffer_load_dwordx4 v[88:91], v1, s[20:23], s33 offen offset:0 nt
    s_waitcnt vmcnt(7)
    buffer_load_dwordx4 v[92:95], v1, s[20:23], s33 offen offset:256 nt
    s_waitcnt vmcnt(7)
    v_cmp_gt_i32 vcc, s30, v53
    s_waitcnt vmcnt(5)
    v_lshlrev_b32 v44, 16, v44
    v_cndmask_b32 v44, v54, v44, vcc
    s_nop 1
    v_add_u32_dpp v45, v44, v1 row_newbcast:2 row_mask:0xf bank_mask:0xf
    buffer_load_dwordx4 v[96:99], v45, s[20:23], 0 offen offset:0 nt
    buffer_load_dwordx4 v[100:103], v45, s[20:23], 0 offen offset:256 nt
    s_waitcnt vmcnt(6)
    v_add_u32_dpp v45, v44, v1 row_newbcast:3 row_mask:0xf bank_mask:0xf
    buffer_load_dwordx4 v[104:107], v45, s[20:23], 0 offen offset:0 nt
    s_waitcnt vmcnt(6)
    buffer_load_dwordx4 v[108:111], v45, s[20:23], 0 offen offset:256 nt
    s_waitcnt vmcnt(6)
    v_mov_b32 v24, v16
    v_mov_b32 v25, v17
    v_mov_b32 v26, v18
    v_mov_b32 v27, v19
    v_permlane32_swap_b32 v16, v24
    v_permlane32_swap_b32 v17, v25
    v_permlane32_swap_b32 v18, v26
    v_permlane32_swap_b32 v19, v27
    v_mov_b32 v20, v16
    v_mov_b32 v21, v17
    v_mov_b32 v22, v18
    v_mov_b32 v23, v19
    v_mov_b32 v28, v24
    v_mov_b32 v29, v25
    v_mov_b32 v30, v26
    v_mov_b32 v31, v27
    v_permlane16_swap_b32 v16, v20
    v_permlane16_swap_b32 v17, v21
    v_permlane16_swap_b32 v18, v22
    v_permlane16_swap_b32 v19, v23
    v_permlane16_swap_b32 v24, v28
    v_permlane16_swap_b32 v25, v29
    v_permlane16_swap_b32 v26, v30
    v_permlane16_swap_b32 v27, v31
    v_dot2c_f32_bf16 v56, v80, v16
    v_dot2c_f32_bf16 v40, v80, v24
    v_dot2c_f32_bf16 v56, v81, v17
    v_dot2c_f32_bf16 v40, v81, v25
    v_dot2c_f32_bf16 v56, v82, v18
    v_dot2c_f32_bf16 v40, v82, v26
    v_dot2c_f32_bf16 v56, v83, v19
    v_dot2c_f32_bf16 v40, v83, v27
    v_dot2c_f32_bf16 v56, v84, v20
    v_dot2c_f32_bf16 v40, v84, v28
    v_dot2c_f32_bf16 v56, v85, v21
    v_dot2c_f32_bf16 v40, v85, v29
    v_dot2c_f32_bf16 v56, v86, v22
    v_dot2c_f32_bf16 v40, v86, v30
    v_dot2c_f32_bf16 v56, v87, v23
    v_dot2c_f32_bf16 v40, v87, v31
    s_waitcnt vmcnt(5)
    v_add_u32_dpp v45, v44, v1 row_newbcast:4 row_mask:0xf bank_mask:0xf
    buffer_load_dwordx4 v[112:115], v45, s[20:23], 0 offen offset:0 nt
    v_dot2c_f32_bf16 v57, v88, v16
    v_dot2c_f32_bf16 v41, v88, v24
    v_dot2c_f32_bf16 v57, v89, v17
    v_add_f32_dpp v56, v40, v56 row_ror:8 row_mask:0xf bank_mask:0xf
    v_dot2c_f32_bf16 v41, v89, v25
    v_dot2c_f32_bf16 v57, v90, v18
    v_add_f32_dpp v56, v56, v56 quad_perm:[1,0,3,2] row_mask:0xf bank_mask:0xf
    v_dot2c_f32_bf16 v41, v90, v26
    v_dot2c_f32_bf16 v57, v91, v19
    v_add_f32_dpp v56, v56, v56 quad_perm:[2,3,0,1] row_mask:0xf bank_mask:0xf
    v_dot2c_f32_bf16 v41, v91, v27
    v_cmp_lt_i32 vcc, 0, v3
    v_add_f32_dpp v56, v56, v56 row_half_mirror row_mask:0xf bank_mask:0xf
    v_mov_b32 v40, 0
    v_cvt_pk_bf16_f32 v56, 0, v56
    v_cndmask_b32 v56, v42, v56, vcc
    v_max_f32 v2, v2, v56
    s_waitcnt vmcnt(5)
    buffer_load_dwordx4 v[116:119], v45, s[20:23], 0 offen offset:256 nt
    v_dot2c_f32_bf16 v57, v92, v20
    v_dot2c_f32_bf16 v41, v92, v28
    v_dot2c_f32_bf16 v57, v93, v21
    v_dot2c_f32_bf16 v41, v93, v29
    v_dot2c_f32_bf16 v57, v94, v22
    v_dot2c_f32_bf16 v41, v94, v30
    v_dot2c_f32_bf16 v57, v95, v23
    v_dot2c_f32_bf16 v41, v95, v31
    s_waitcnt vmcnt(5)
    v_add_u32_dpp v45, v44, v1 row_newbcast:5 row_mask:0xf bank_mask:0xf
    buffer_load_dwordx4 v[120:123], v45, s[20:23], 0 offen offset:0 nt
    v_dot2c_f32_bf16 v58, v96, v16
    v_dot2c_f32_bf16 v40, v96, v24
    v_dot2c_f32_bf16 v58, v97, v17
    v_add_f32_dpp v57, v41, v57 row_ror:8 row_mask:0xf bank_mask:0xf
    v_dot2c_f32_bf16 v40, v97, v25
    v_dot2c_f32_bf16 v58, v98, v18
    v_add_f32_dpp v57, v57, v57 quad_perm:[1,0,3,2] row_mask:0xf bank_mask:0xf
    v_dot2c_f32_bf16 v40, v98, v26
    v_dot2c_f32_bf16 v58, v99, v19
    v_add_f32_dpp v57, v57, v57 quad_perm:[2,3,0,1] row_mask:0xf bank_mask:0xf
    v_dot2c_f32_bf16 v40, v99, v27
    v_cmp_lt_i32 vcc, 512, v3
    v_add_f32_dpp v57, v57, v57 row_half_mirror row_mask:0xf bank_mask:0xf
    v_mov_b32 v41, 0
    v_cvt_pk_bf16_f32 v57, 0, v57
    v_cndmask_b32 v57, v42, v57, vcc
    v_max_f32 v2, v2, v57
    s_waitcnt vmcnt(5)
    buffer_load_dwordx4 v[124:127], v45, s[20:23], 0 offen offset:256 nt
    v_dot2c_f32_bf16 v58, v100, v20
    v_dot2c_f32_bf16 v40, v100, v28
    v_dot2c_f32_bf16 v58, v101, v21
    v_dot2c_f32_bf16 v40, v101, v29
    v_dot2c_f32_bf16 v58, v102, v22
    v_dot2c_f32_bf16 v40, v102, v30
    v_dot2c_f32_bf16 v58, v103, v23
    v_dot2c_f32_bf16 v40, v103, v31
    s_waitcnt vmcnt(5)
    v_add_u32_dpp v45, v44, v1 row_newbcast:6 row_mask:0xf bank_mask:0xf
    buffer_load_dwordx4 v[128:131], v45, s[20:23], 0 offen offset:0 nt
    v_dot2c_f32_bf16 v59, v104, v16
    v_dot2c_f32_bf16 v41, v104, v24
    v_dot2c_f32_bf16 v59, v105, v17
    v_add_f32_dpp v58, v40, v58 row_ror:8 row_mask:0xf bank_mask:0xf
    v_dot2c_f32_bf16 v41, v105, v25
    v_dot2c_f32_bf16 v59, v106, v18
    v_add_f32_dpp v58, v58, v58 quad_perm:[1,0,3,2] row_mask:0xf bank_mask:0xf
    v_dot2c_f32_bf16 v41, v106, v26
    v_dot2c_f32_bf16 v59, v107, v19
    v_add_f32_dpp v58, v58, v58 quad_perm:[2,3,0,1] row_mask:0xf bank_mask:0xf
    v_dot2c_f32_bf16 v41, v107, v27
    v_cmp_lt_i32 vcc, 1024, v3
    v_add_f32_dpp v58, v58, v58 row_half_mirror row_mask:0xf bank_mask:0xf
    v_mov_b32 v40, 0
    v_cvt_pk_bf16_f32 v58, 0, v58
    v_cndmask_b32 v58, v42, v58, vcc
    v_max_f32 v2, v2, v58
    s_waitcnt vmcnt(5)
    buffer_load_dwordx4 v[132:135], v45, s[20:23], 0 offen offset:256 nt
    v_dot2c_f32_bf16 v59, v108, v20
    v_dot2c_f32_bf16 v41, v108, v28
    v_dot2c_f32_bf16 v59, v109, v21
    v_dot2c_f32_bf16 v41, v109, v29
    v_dot2c_f32_bf16 v59, v110, v22
    v_dot2c_f32_bf16 v41, v110, v30
    v_dot2c_f32_bf16 v59, v111, v23
    v_dot2c_f32_bf16 v41, v111, v31
    s_waitcnt vmcnt(5)
    v_add_u32_dpp v45, v44, v1 row_newbcast:7 row_mask:0xf bank_mask:0xf
    buffer_load_dwordx4 v[136:139], v45, s[20:23], 0 offen offset:0 nt
    v_dot2c_f32_bf16 v60, v112, v16
    v_dot2c_f32_bf16 v40, v112, v24
    v_dot2c_f32_bf16 v60, v113, v17
    v_add_f32_dpp v59, v41, v59 row_ror:8 row_mask:0xf bank_mask:0xf
    v_dot2c_f32_bf16 v40, v113, v25
    v_dot2c_f32_bf16 v60, v114, v18
    v_add_f32_dpp v59, v59, v59 quad_perm:[1,0,3,2] row_mask:0xf bank_mask:0xf
    v_dot2c_f32_bf16 v40, v114, v26
    v_dot2c_f32_bf16 v60, v115, v19
    v_add_f32_dpp v59, v59, v59 quad_perm:[2,3,0,1] row_mask:0xf bank_mask:0xf
    v_dot2c_f32_bf16 v40, v115, v27
    v_cmp_lt_i32 vcc, 1536, v3
    v_add_f32_dpp v59, v59, v59 row_half_mirror row_mask:0xf bank_mask:0xf
    v_mov_b32 v41, 0
    v_cvt_pk_bf16_f32 v59, 0, v59
    v_cndmask_b32 v59, v42, v59, vcc
    v_max_f32 v2, v2, v59
    s_waitcnt vmcnt(5)
    buffer_load_dwordx4 v[140:143], v45, s[20:23], 0 offen offset:256 nt
    v_dot2c_f32_bf16 v60, v116, v20
    v_dot2c_f32_bf16 v40, v116, v28
    v_dot2c_f32_bf16 v60, v117, v21
    v_dot2c_f32_bf16 v40, v117, v29
    v_dot2c_f32_bf16 v60, v118, v22
    v_dot2c_f32_bf16 v40, v118, v30
    v_dot2c_f32_bf16 v60, v119, v23
    v_dot2c_f32_bf16 v40, v119, v31
    v_and_b32 v53, 1, v0
    v_lshlrev_b32 v53, 4, v53
    v_mov_b32 v54, 0xffff
    v_lshlrev_b32 v53, v53, v54
    v_bfe_u32 v54, v0, 1, 2
    v_cmp_eq_u32 s[48:49], 0, v54
    v_cmp_eq_u32 s[50:51], 1, v54
    v_cmp_eq_u32 s[52:53], 2, v54
    v_cmp_eq_u32 s[54:55], 3, v54
    v_cndmask_b32 v4, 0, v53, s[48:49]
    v_cndmask_b32 v5, 0, v53, s[50:51]
    v_cndmask_b32 v6, 0, v53, s[52:53]
    v_cndmask_b32 v7, 0, v53, s[54:55]
    s_waitcnt vmcnt(5)
    v_add_u32_dpp v45, v44, v1 row_newbcast:8 row_mask:0xf bank_mask:0xf
    buffer_load_dwordx4 v[144:147], v45, s[20:23], 0 offen offset:0 nt
    v_dot2c_f32_bf16 v61, v120, v16
    v_dot2c_f32_bf16 v41, v120, v24
    v_dot2c_f32_bf16 v61, v121, v17
    v_add_f32_dpp v60, v40, v60 row_ror:8 row_mask:0xf bank_mask:0xf
    v_dot2c_f32_bf16 v41, v121, v25
    v_dot2c_f32_bf16 v61, v122, v18
    v_add_f32_dpp v60, v60, v60 quad_perm:[1,0,3,2] row_mask:0xf bank_mask:0xf
    v_dot2c_f32_bf16 v41, v122, v26
    v_dot2c_f32_bf16 v61, v123, v19
    v_add_f32_dpp v60, v60, v60 quad_perm:[2,3,0,1] row_mask:0xf bank_mask:0xf
    v_dot2c_f32_bf16 v41, v123, v27
    v_cmp_lt_i32 vcc, 2048, v3
    v_add_f32_dpp v60, v60, v60 row_half_mirror row_mask:0xf bank_mask:0xf
    v_mov_b32 v40, 0
    v_cvt_pk_bf16_f32 v60, 0, v60
    v_cndmask_b32 v60, v42, v60, vcc
    v_max_f32 v2, v2, v60
    s_waitcnt vmcnt(5)
    buffer_load_dwordx4 v[148:151], v45, s[20:23], 0 offen offset:256 nt
    v_dot2c_f32_bf16 v61, v124, v20
    v_dot2c_f32_bf16 v41, v124, v28
    v_dot2c_f32_bf16 v61, v125, v21
    v_dot2c_f32_bf16 v41, v125, v29
    v_dot2c_f32_bf16 v61, v126, v22
    v_dot2c_f32_bf16 v41, v126, v30
    v_dot2c_f32_bf16 v61, v127, v23
    v_dot2c_f32_bf16 v41, v127, v31
    s_lshl_b32 s66, s3, 11
    v_lshl_add_u32 v43, v0, 4, s66
    s_lshl_b32 s66, s3, 9
    v_lshl_add_u32 v75, v0, 3, s66
    v_lshrrev_b32 v53, 3, v0
    v_lshl_add_u32 v53, s3, 3, v53
    v_lshlrev_b32 v76, 2, v53
    s_and_b32 s66, s3, 1
    s_lshl_b32 s66, s66, 4
    v_mov_b32 v77, s66
    v_lshlrev_b32 v54, 1, v53
    v_xor_b32 v54, s28, v54
    v_and_b32 v54, 31, v54
    v_lshl_add_u32 v53, s29, 5, v53
    v_lshl_add_u32 v53, v53, 5, v54
    v_and_b32 v54, 7, v0
    v_lshlrev_b32 v54, 3, v54
    v_lshl_add_u32 v78, v53, 6, v54
    s_movk_i32 s44, 0x3ff
    s_waitcnt vmcnt(5)
    v_add_u32_dpp v45, v44, v1 row_newbcast:9 row_mask:0xf bank_mask:0xf
    buffer_load_dwordx4 v[152:155], v45, s[20:23], 0 offen offset:0 nt
    v_dot2c_f32_bf16 v62, v128, v16
    v_dot2c_f32_bf16 v40, v128, v24
    v_dot2c_f32_bf16 v62, v129, v17
    v_add_f32_dpp v61, v41, v61 row_ror:8 row_mask:0xf bank_mask:0xf
    v_dot2c_f32_bf16 v40, v129, v25
    v_dot2c_f32_bf16 v62, v130, v18
    v_add_f32_dpp v61, v61, v61 quad_perm:[1,0,3,2] row_mask:0xf bank_mask:0xf
    v_dot2c_f32_bf16 v40, v130, v26
    v_dot2c_f32_bf16 v62, v131, v19
    v_add_f32_dpp v61, v61, v61 quad_perm:[2,3,0,1] row_mask:0xf bank_mask:0xf
    v_dot2c_f32_bf16 v40, v131, v27
    v_cmp_lt_i32 vcc, 2560, v3
    v_add_f32_dpp v61, v61, v61 row_half_mirror row_mask:0xf bank_mask:0xf
    v_mov_b32 v41, 0
    v_cvt_pk_bf16_f32 v61, 0, v61
    v_cndmask_b32 v61, v42, v61, vcc
    v_max_f32 v2, v2, v61
    s_waitcnt vmcnt(5)
    buffer_load_dwordx4 v[156:159], v45, s[20:23], 0 offen offset:256 nt
    v_dot2c_f32_bf16 v62, v132, v20
    v_dot2c_f32_bf16 v40, v132, v28
    v_dot2c_f32_bf16 v62, v133, v21
    v_dot2c_f32_bf16 v40, v133, v29
    v_dot2c_f32_bf16 v62, v134, v22
    v_dot2c_f32_bf16 v40, v134, v30
    v_dot2c_f32_bf16 v62, v135, v23
    v_dot2c_f32_bf16 v40, v135, v31
    v_bfe_u32 v53, v0, 2, 2
    v_and_b32 v54, 48, v0
    v_add_lshl_u32 v72, v53, v54, 2
    v_and_b32 v53, 3, v0
    v_lshlrev_b32 v53, 7, v53
    v_lshl_add_u32 v73, v54, 8, v53
    v_bfe_u32 v50, v0, 3, 1
    v_lshl_add_u32 v50, v50, 5, v46
    s_waitcnt vmcnt(5)
    v_add_u32_dpp v45, v44, v1 row_newbcast:10 row_mask:0xf bank_mask:0xf
    buffer_load_dwordx4 v[160:163], v45, s[20:23], 0 offen offset:0 nt
    v_dot2c_f32_bf16 v63, v136, v16
    v_dot2c_f32_bf16 v41, v136, v24
    v_dot2c_f32_bf16 v63, v137, v17
    v_add_f32_dpp v62, v40, v62 row_ror:8 row_mask:0xf bank_mask:0xf
    v_dot2c_f32_bf16 v41, v137, v25
    v_dot2c_f32_bf16 v63, v138, v18
    v_add_f32_dpp v62, v62, v62 quad_perm:[1,0,3,2] row_mask:0xf bank_mask:0xf
    v_dot2c_f32_bf16 v41, v138, v26
    v_dot2c_f32_bf16 v63, v139, v19
    v_add_f32_dpp v62, v62, v62 quad_perm:[2,3,0,1] row_mask:0xf bank_mask:0xf
    v_dot2c_f32_bf16 v41, v139, v27
    v_cmp_lt_i32 vcc, 3072, v3
    v_add_f32_dpp v62, v62, v62 row_half_mirror row_mask:0xf bank_mask:0xf
    v_mov_b32 v40, 0
    v_cvt_pk_bf16_f32 v62, 0, v62
    v_cndmask_b32 v62, v42, v62, vcc
    v_max_f32 v2, v2, v62
    s_waitcnt vmcnt(5)
    buffer_load_dwordx4 v[164:167], v45, s[20:23], 0 offen offset:256 nt
    v_dot2c_f32_bf16 v63, v140, v20
    v_dot2c_f32_bf16 v41, v140, v28
    v_dot2c_f32_bf16 v63, v141, v21
    v_dot2c_f32_bf16 v41, v141, v29
    v_dot2c_f32_bf16 v63, v142, v22
    v_dot2c_f32_bf16 v41, v142, v30
    v_dot2c_f32_bf16 v63, v143, v23
    v_dot2c_f32_bf16 v41, v143, v31
    s_waitcnt vmcnt(5)
    v_add_u32_dpp v45, v44, v1 row_newbcast:11 row_mask:0xf bank_mask:0xf
    buffer_load_dwordx4 v[80:83], v45, s[20:23], 0 offen offset:0 nt
    v_dot2c_f32_bf16 v64, v144, v16
    v_dot2c_f32_bf16 v40, v144, v24
    v_dot2c_f32_bf16 v64, v145, v17
    v_add_f32_dpp v63, v41, v63 row_ror:8 row_mask:0xf bank_mask:0xf
    v_dot2c_f32_bf16 v40, v145, v25
    v_dot2c_f32_bf16 v64, v146, v18
    v_add_f32_dpp v63, v63, v63 quad_perm:[1,0,3,2] row_mask:0xf bank_mask:0xf
    v_dot2c_f32_bf16 v40, v146, v26
    v_dot2c_f32_bf16 v64, v147, v19
    v_add_f32_dpp v63, v63, v63 quad_perm:[2,3,0,1] row_mask:0xf bank_mask:0xf
    v_dot2c_f32_bf16 v40, v147, v27
    v_cmp_lt_i32 vcc, 3584, v3
    v_add_f32_dpp v63, v63, v63 row_half_mirror row_mask:0xf bank_mask:0xf
    v_mov_b32 v41, 0
    v_cvt_pk_bf16_f32 v63, 0, v63
    v_cndmask_b32 v63, v42, v63, vcc
    v_max_f32 v2, v2, v63
    s_waitcnt vmcnt(5)
    buffer_load_dwordx4 v[84:87], v45, s[20:23], 0 offen offset:256 nt
    v_dot2c_f32_bf16 v64, v148, v20
    v_dot2c_f32_bf16 v40, v148, v28
    v_dot2c_f32_bf16 v64, v149, v21
    v_dot2c_f32_bf16 v40, v149, v29
    v_dot2c_f32_bf16 v64, v150, v22
    v_dot2c_f32_bf16 v40, v150, v30
    v_dot2c_f32_bf16 v64, v151, v23
    v_dot2c_f32_bf16 v40, v151, v31
    s_waitcnt vmcnt(5)
    v_add_u32_dpp v45, v44, v1 row_newbcast:12 row_mask:0xf bank_mask:0xf
    buffer_load_dwordx4 v[88:91], v45, s[20:23], 0 offen offset:0 nt
    v_dot2c_f32_bf16 v65, v152, v16
    v_dot2c_f32_bf16 v41, v152, v24
    v_dot2c_f32_bf16 v65, v153, v17
    v_add_f32_dpp v64, v40, v64 row_ror:8 row_mask:0xf bank_mask:0xf
    v_dot2c_f32_bf16 v41, v153, v25
    v_dot2c_f32_bf16 v65, v154, v18
    v_add_f32_dpp v64, v64, v64 quad_perm:[1,0,3,2] row_mask:0xf bank_mask:0xf
    v_dot2c_f32_bf16 v41, v154, v26
    v_dot2c_f32_bf16 v65, v155, v19
    v_add_f32_dpp v64, v64, v64 quad_perm:[2,3,0,1] row_mask:0xf bank_mask:0xf
    v_dot2c_f32_bf16 v41, v155, v27
    v_cmp_lt_i32 vcc, 4096, v3
    v_add_f32_dpp v64, v64, v64 row_half_mirror row_mask:0xf bank_mask:0xf
    v_mov_b32 v40, 0
    v_cvt_pk_bf16_f32 v64, 0, v64
    v_cndmask_b32 v64, v42, v64, vcc
    v_max_f32 v2, v2, v64
    s_waitcnt vmcnt(5)
    buffer_load_dwordx4 v[92:95], v45, s[20:23], 0 offen offset:256 nt
    v_dot2c_f32_bf16 v65, v156, v20
    v_dot2c_f32_bf16 v41, v156, v28
    v_dot2c_f32_bf16 v65, v157, v21
    v_dot2c_f32_bf16 v41, v157, v29
    v_dot2c_f32_bf16 v65, v158, v22
    v_dot2c_f32_bf16 v41, v158, v30
    v_dot2c_f32_bf16 v65, v159, v23
    v_dot2c_f32_bf16 v41, v159, v31
    s_waitcnt vmcnt(5)
    v_add_u32_dpp v45, v44, v1 row_newbcast:13 row_mask:0xf bank_mask:0xf
    buffer_load_dwordx4 v[96:99], v45, s[20:23], 0 offen offset:0 nt
    v_mov_b32 v55, 1
    s_mov_b64 exec, 1
    ds_write_b32 v46, v55 offset:192
    s_mov_b64 exec, -1
    v_dot2c_f32_bf16 v66, v160, v16
    v_dot2c_f32_bf16 v40, v160, v24
    v_dot2c_f32_bf16 v66, v161, v17
    v_add_f32_dpp v65, v41, v65 row_ror:8 row_mask:0xf bank_mask:0xf
    v_dot2c_f32_bf16 v40, v161, v25
    v_dot2c_f32_bf16 v66, v162, v18
    v_add_f32_dpp v65, v65, v65 quad_perm:[1,0,3,2] row_mask:0xf bank_mask:0xf
    v_dot2c_f32_bf16 v40, v162, v26
    v_dot2c_f32_bf16 v66, v163, v19
    v_add_f32_dpp v65, v65, v65 quad_perm:[2,3,0,1] row_mask:0xf bank_mask:0xf
    v_dot2c_f32_bf16 v40, v163, v27
    v_cmp_lt_i32 vcc, 4608, v3
    v_add_f32_dpp v65, v65, v65 row_half_mirror row_mask:0xf bank_mask:0xf
    v_mov_b32 v41, 0
    v_cvt_pk_bf16_f32 v65, 0, v65
    v_cndmask_b32 v65, v42, v65, vcc
    v_max_f32 v2, v2, v65
    s_waitcnt vmcnt(5)
    buffer_load_dwordx4 v[100:103], v45, s[20:23], 0 offen offset:256 nt
    v_dot2c_f32_bf16 v66, v164, v20
    v_dot2c_f32_bf16 v40, v164, v28
    v_dot2c_f32_bf16 v66, v165, v21
    v_dot2c_f32_bf16 v40, v165, v29
    v_dot2c_f32_bf16 v66, v166, v22
    v_dot2c_f32_bf16 v40, v166, v30
    v_dot2c_f32_bf16 v66, v167, v23
    v_dot2c_f32_bf16 v40, v167, v31
    s_waitcnt vmcnt(5)
    v_add_u32_dpp v45, v44, v1 row_newbcast:14 row_mask:0xf bank_mask:0xf
    buffer_load_dwordx4 v[104:107], v45, s[20:23], 0 offen offset:0 nt
    v_dot2c_f32_bf16 v67, v80, v16
    v_dot2c_f32_bf16 v41, v80, v24
    v_dot2c_f32_bf16 v67, v81, v17
    v_add_f32_dpp v66, v40, v66 row_ror:8 row_mask:0xf bank_mask:0xf
    v_dot2c_f32_bf16 v41, v81, v25
    v_dot2c_f32_bf16 v67, v82, v18
    v_add_f32_dpp v66, v66, v66 quad_perm:[1,0,3,2] row_mask:0xf bank_mask:0xf
    v_dot2c_f32_bf16 v41, v82, v26
    v_dot2c_f32_bf16 v67, v83, v19
    v_add_f32_dpp v66, v66, v66 quad_perm:[2,3,0,1] row_mask:0xf bank_mask:0xf
    v_dot2c_f32_bf16 v41, v83, v27
    v_cmp_lt_i32 vcc, 5120, v3
    v_add_f32_dpp v66, v66, v66 row_half_mirror row_mask:0xf bank_mask:0xf
    v_mov_b32 v40, 0
    v_cvt_pk_bf16_f32 v66, 0, v66
    v_cndmask_b32 v66, v42, v66, vcc
    v_max_f32 v2, v2, v66
    s_waitcnt vmcnt(5)
    buffer_load_dwordx4 v[108:111], v45, s[20:23], 0 offen offset:256 nt
    v_add_u32_dpp v45, v44, v1 row_newbcast:15 row_mask:0xf bank_mask:0xf
    buffer_load_dwordx4 v[112:115], v45, s[20:23], 0 offen offset:0 nt
    buffer_load_dwordx4 v[116:119], v45, s[20:23], 0 offen offset:256 nt
    v_add_u32_dpp v45, v44, v1 row_newbcast:15 row_mask:0xf bank_mask:0xf
    buffer_load_dwordx4 v[120:123], v45, s[24:27], 0 offen offset:0 nt
    buffer_load_dwordx4 v[124:127], v45, s[24:27], 0 offen offset:256 nt
    v_add_u32_dpp v45, v44, v1 row_newbcast:0 row_mask:0xf bank_mask:0xf
    buffer_load_dwordx4 v[128:131], v45, s[24:27], 0 offen offset:0
    v_dot2c_f32_bf16 v67, v84, v20
    v_dot2c_f32_bf16 v41, v84, v28
    v_dot2c_f32_bf16 v67, v85, v21
    v_dot2c_f32_bf16 v41, v85, v29
    v_dot2c_f32_bf16 v67, v86, v22
    v_dot2c_f32_bf16 v41, v86, v30
    v_dot2c_f32_bf16 v67, v87, v23
    v_dot2c_f32_bf16 v41, v87, v31
    s_waitcnt vmcnt(10)
    buffer_load_dwordx4 v[132:135], v45, s[24:27], 0 offen offset:256 nt
    v_add_u32_dpp v45, v44, v1 row_newbcast:1 row_mask:0xf bank_mask:0xf
    buffer_load_dwordx4 v[136:139], v45, s[24:27], 0 offen offset:0
    v_dot2c_f32_bf16 v68, v88, v16
    v_dot2c_f32_bf16 v40, v88, v24
    v_dot2c_f32_bf16 v68, v89, v17
    v_add_f32_dpp v67, v41, v67 row_ror:8 row_mask:0xf bank_mask:0xf
    v_dot2c_f32_bf16 v40, v89, v25
    v_dot2c_f32_bf16 v68, v90, v18
    v_add_f32_dpp v67, v67, v67 quad_perm:[1,0,3,2] row_mask:0xf bank_mask:0xf
    v_dot2c_f32_bf16 v40, v90, v26
    v_dot2c_f32_bf16 v68, v91, v19
    v_add_f32_dpp v67, v67, v67 quad_perm:[2,3,0,1] row_mask:0xf bank_mask:0xf
    v_dot2c_f32_bf16 v40, v91, v27
    v_cmp_lt_i32 vcc, 5632, v3
    v_add_f32_dpp v67, v67, v67 row_half_mirror row_mask:0xf bank_mask:0xf
    v_mov_b32 v41, 0
    v_cvt_pk_bf16_f32 v67, 0, v67
    v_cndmask_b32 v67, v42, v67, vcc
    v_max_f32 v2, v2, v67
    s_waitcnt vmcnt(11)
    buffer_load_dwordx4 v[140:143], v45, s[24:27], 0 offen offset:256 nt
    v_add_u32_dpp v45, v44, v1 row_newbcast:2 row_mask:0xf bank_mask:0xf
    buffer_load_dwordx4 v[144:147], v45, s[24:27], 0 offen offset:0
    v_dot2c_f32_bf16 v68, v92, v20
    v_dot2c_f32_bf16 v40, v92, v28
    v_dot2c_f32_bf16 v68, v93, v21
    v_dot2c_f32_bf16 v40, v93, v29
    v_dot2c_f32_bf16 v68, v94, v22
    v_dot2c_f32_bf16 v40, v94, v30
    v_dot2c_f32_bf16 v68, v95, v23
    v_dot2c_f32_bf16 v40, v95, v31
    s_waitcnt vmcnt(12)
    buffer_load_dwordx4 v[148:151], v45, s[24:27], 0 offen offset:256 nt
    v_add_u32_dpp v45, v44, v1 row_newbcast:3 row_mask:0xf bank_mask:0xf
    buffer_load_dwordx4 v[152:155], v45, s[24:27], 0 offen offset:0
    v_dot2c_f32_bf16 v69, v96, v16
    v_dot2c_f32_bf16 v41, v96, v24
    v_dot2c_f32_bf16 v69, v97, v17
    v_add_f32_dpp v68, v40, v68 row_ror:8 row_mask:0xf bank_mask:0xf
    v_dot2c_f32_bf16 v41, v97, v25
    v_dot2c_f32_bf16 v69, v98, v18
    v_add_f32_dpp v68, v68, v68 quad_perm:[1,0,3,2] row_mask:0xf bank_mask:0xf
    v_dot2c_f32_bf16 v41, v98, v26
    v_dot2c_f32_bf16 v69, v99, v19
    v_add_f32_dpp v68, v68, v68 quad_perm:[2,3,0,1] row_mask:0xf bank_mask:0xf
    v_dot2c_f32_bf16 v41, v99, v27
    v_cmp_lt_i32 vcc, 6144, v3
    v_add_f32_dpp v68, v68, v68 row_half_mirror row_mask:0xf bank_mask:0xf
    v_mov_b32 v40, 0
    v_cvt_pk_bf16_f32 v68, 0, v68
    v_cndmask_b32 v68, v42, v68, vcc
    v_max_f32 v2, v2, v68
    s_waitcnt vmcnt(13)
    buffer_load_dwordx4 v[156:159], v45, s[24:27], 0 offen offset:256 nt
    v_dot2c_f32_bf16 v69, v100, v20
    v_dot2c_f32_bf16 v41, v100, v28
    v_dot2c_f32_bf16 v69, v101, v21
    v_dot2c_f32_bf16 v41, v101, v29
    v_dot2c_f32_bf16 v69, v102, v22
    v_dot2c_f32_bf16 v41, v102, v30
    v_dot2c_f32_bf16 v69, v103, v23
    v_dot2c_f32_bf16 v41, v103, v31
    s_waitcnt vmcnt(13)
    v_add_u32_dpp v45, v44, v1 row_newbcast:4 row_mask:0xf bank_mask:0xf
    buffer_load_dwordx4 v[160:163], v45, s[24:27], 0 offen offset:0 nt
    v_dot2c_f32_bf16 v70, v104, v16
    v_dot2c_f32_bf16 v40, v104, v24
    v_dot2c_f32_bf16 v70, v105, v17
    v_add_f32_dpp v69, v41, v69 row_ror:8 row_mask:0xf bank_mask:0xf
    v_dot2c_f32_bf16 v40, v105, v25
    v_dot2c_f32_bf16 v70, v106, v18
    v_add_f32_dpp v69, v69, v69 quad_perm:[1,0,3,2] row_mask:0xf bank_mask:0xf
    v_dot2c_f32_bf16 v40, v106, v26
    v_dot2c_f32_bf16 v70, v107, v19
    v_add_f32_dpp v69, v69, v69 quad_perm:[2,3,0,1] row_mask:0xf bank_mask:0xf
    v_dot2c_f32_bf16 v40, v107, v27
    v_cmp_lt_i32 vcc, 6656, v3
    v_add_f32_dpp v69, v69, v69 row_half_mirror row_mask:0xf bank_mask:0xf
    v_mov_b32 v41, 0
    v_cvt_pk_bf16_f32 v69, 0, v69
    v_cndmask_b32 v69, v42, v69, vcc
    v_max_f32 v2, v2, v69
    s_waitcnt vmcnt(13)
    buffer_load_dwordx4 v[164:167], v45, s[24:27], 0 offen offset:256 nt
    v_dot2c_f32_bf16 v70, v108, v20
    v_dot2c_f32_bf16 v40, v108, v28
    v_dot2c_f32_bf16 v70, v109, v21
    v_dot2c_f32_bf16 v40, v109, v29
    v_dot2c_f32_bf16 v70, v110, v22
    v_dot2c_f32_bf16 v40, v110, v30
    v_dot2c_f32_bf16 v70, v111, v23
    v_dot2c_f32_bf16 v40, v111, v31
    s_waitcnt vmcnt(13)
    v_dot2c_f32_bf16 v71, v112, v16
    v_dot2c_f32_bf16 v41, v112, v24
    v_dot2c_f32_bf16 v71, v113, v17
    v_add_f32_dpp v70, v40, v70 row_ror:8 row_mask:0xf bank_mask:0xf
    v_dot2c_f32_bf16 v41, v113, v25
    v_dot2c_f32_bf16 v71, v114, v18
    v_add_f32_dpp v70, v70, v70 quad_perm:[1,0,3,2] row_mask:0xf bank_mask:0xf
    v_dot2c_f32_bf16 v41, v114, v26
    v_dot2c_f32_bf16 v71, v115, v19
    v_add_f32_dpp v70, v70, v70 quad_perm:[2,3,0,1] row_mask:0xf bank_mask:0xf
    v_dot2c_f32_bf16 v41, v115, v27
    v_cmp_lt_i32 vcc, 7168, v3
    v_add_f32_dpp v70, v70, v70 row_half_mirror row_mask:0xf bank_mask:0xf
    v_mov_b32 v40, 0
    v_cvt_pk_bf16_f32 v70, 0, v70
    v_cndmask_b32 v70, v42, v70, vcc
    v_max_f32 v2, v2, v70
    s_waitcnt vmcnt(12)
    v_dot2c_f32_bf16 v71, v116, v20
    v_dot2c_f32_bf16 v41, v116, v28
    v_dot2c_f32_bf16 v71, v117, v21
    v_dot2c_f32_bf16 v41, v117, v29
    v_dot2c_f32_bf16 v71, v118, v22
    v_dot2c_f32_bf16 v41, v118, v30
    v_dot2c_f32_bf16 v71, v119, v23
    v_dot2c_f32_bf16 v41, v119, v31
    s_nop 2
    v_add_f32_dpp v71, v41, v71 row_ror:8 row_mask:0xf bank_mask:0xf
    v_cmp_lt_i32 vcc, 7680, v3
    s_nop 0
    v_add_f32_dpp v71, v71, v71 quad_perm:[1,0,3,2] row_mask:0xf bank_mask:0xf
    s_nop 1
    v_add_f32_dpp v71, v71, v71 quad_perm:[2,3,0,1] row_mask:0xf bank_mask:0xf
    s_nop 1
    v_add_f32_dpp v71, v71, v71 row_half_mirror row_mask:0xf bank_mask:0xf
    v_cvt_pk_bf16_f32 v71, 0, v71
    v_cndmask_b32 v71, v42, v71, vcc
    v_max_f32 v2, v2, v71
    v_mov_b32 v48, v2
    s_nop 1
    v_permlane16_swap_b32 v48, v2
    v_max_f32 v2, v2, v48
    v_mov_b32 v48, v2
    s_nop 1
    v_permlane32_swap_b32 v48, v2
    v_max_f32 v2, v2, v48
    v_pk_add_f32 v[56:57], v[56:57], v[2:3] op_sel_hi:[1,0] neg_lo:[0,1] neg_hi:[0,1]
    v_pk_add_f32 v[58:59], v[58:59], v[2:3] op_sel_hi:[1,0] neg_lo:[0,1] neg_hi:[0,1]
    v_pk_add_f32 v[60:61], v[60:61], v[2:3] op_sel_hi:[1,0] neg_lo:[0,1] neg_hi:[0,1]
    v_pk_add_f32 v[62:63], v[62:63], v[2:3] op_sel_hi:[1,0] neg_lo:[0,1] neg_hi:[0,1]
    v_pk_add_f32 v[64:65], v[64:65], v[2:3] op_sel_hi:[1,0] neg_lo:[0,1] neg_hi:[0,1]
    v_pk_add_f32 v[66:67], v[66:67], v[2:3] op_sel_hi:[1,0] neg_lo:[0,1] neg_hi:[0,1]
    v_pk_add_f32 v[68:69], v[68:69], v[2:3] op_sel_hi:[1,0] neg_lo:[0,1] neg_hi:[0,1]
    v_pk_add_f32 v[70:71], v[70:71], v[2:3] op_sel_hi:[1,0] neg_lo:[0,1] neg_hi:[0,1]
    v_pk_mul_f32 v[56:57], v[56:57], s[36:37] op_sel_hi:[1,0]
    v_pk_mul_f32 v[58:59], v[58:59], s[36:37] op_sel_hi:[1,0]
    v_pk_mul_f32 v[60:61], v[60:61], s[36:37] op_sel_hi:[1,0]
    v_pk_mul_f32 v[62:63], v[62:63], s[36:37] op_sel_hi:[1,0]
    v_pk_mul_f32 v[64:65], v[64:65], s[36:37] op_sel_hi:[1,0]
    v_pk_mul_f32 v[66:67], v[66:67], s[36:37] op_sel_hi:[1,0]
    v_pk_mul_f32 v[68:69], v[68:69], s[36:37] op_sel_hi:[1,0]
    v_pk_mul_f32 v[70:71], v[70:71], s[36:37] op_sel_hi:[1,0]
    s_waitcnt vmcnt(8)
    v_add_u32_dpp v45, v44, v1 row_newbcast:5 row_mask:0xf bank_mask:0xf
    buffer_load_dwordx4 v[80:83], v45, s[24:27], 0 offen offset:0 nt
    v_exp_f32 v56, v56
    v_exp_f32 v57, v57
    v_exp_f32 v58, v58
    v_exp_f32 v59, v59
    v_exp_f32 v60, v60
    v_exp_f32 v61, v61
    v_exp_f32 v62, v62
    v_exp_f32 v63, v63
    v_exp_f32 v64, v64
    v_exp_f32 v65, v65
    v_exp_f32 v66, v66
    v_exp_f32 v67, v67
    v_exp_f32 v68, v68
    v_exp_f32 v69, v69
    v_exp_f32 v70, v70
    v_exp_f32 v71, v71
    v_pk_add_f32 v[48:49], v[56:57], v[58:59]
    v_pk_add_f32 v[48:49], v[48:49], v[60:61]
    v_pk_add_f32 v[48:49], v[48:49], v[62:63]
    v_pk_add_f32 v[48:49], v[48:49], v[64:65]
    v_pk_add_f32 v[48:49], v[48:49], v[66:67]
    v_pk_add_f32 v[48:49], v[48:49], v[68:69]
    v_pk_add_f32 v[48:49], v[48:49], v[70:71]
    v_add_f32 v49, v48, v49
    v_mov_b32 v48, v49
    s_nop 1
    v_permlane16_swap_b32 v48, v49
    v_add_f32 v49, v49, v48
    v_mov_b32 v48, v49
    s_nop 1
    v_permlane32_swap_b32 v48, v49
    v_add_f32 v49, v49, v48
    s_mov_b64 exec, 0x101
    ds_write2_b32 v50, v2, v49 offset0:0 offset1:4
    s_mov_b64 exec, -1
    v_cvt_pk_bf16_f32 v48, v71, v71
    v_and_b32 v32, v48, v4
    v_and_b32 v33, v48, v5
    v_and_b32 v34, v48, v6
    v_and_b32 v35, v48, v7
    s_nop 1
    v_mfma_f32_16x16x32_bf16 v[8:11], v[32:35], v[120:123], 0
    v_cvt_pk_bf16_f32 v48, v56, v56
    v_and_b32 v36, v48, v4
    v_and_b32 v37, v48, v5
    v_and_b32 v38, v48, v6
    v_and_b32 v39, v48, v7
    v_mfma_f32_16x16x32_bf16 v[12:15], v[32:35], v[124:127], 0
    s_nop 0
    v_mfma_f32_16x16x32_bf16 v[8:11], v[36:39], v[128:131], v[8:11]
    v_cvt_pk_bf16_f32 v48, v57, v57
    v_and_b32 v32, v48, v4
    v_and_b32 v33, v48, v5
    v_and_b32 v34, v48, v6
    v_and_b32 v35, v48, v7
    v_mfma_f32_16x16x32_bf16 v[12:15], v[36:39], v[132:135], v[12:15]
    s_waitcnt vmcnt(8)
    v_mfma_f32_16x16x32_bf16 v[8:11], v[32:35], v[136:139], v[8:11]
    v_cvt_pk_bf16_f32 v48, v58, v58
    v_and_b32 v36, v48, v4
    v_and_b32 v37, v48, v5
    v_and_b32 v38, v48, v6
    v_and_b32 v39, v48, v7
    s_waitcnt vmcnt(7)
    buffer_load_dwordx4 v[84:87], v45, s[24:27], 0 offen offset:256 nt
    v_mfma_f32_16x16x32_bf16 v[12:15], v[32:35], v[140:143], v[12:15]
    s_waitcnt vmcnt(7)
    v_mfma_f32_16x16x32_bf16 v[8:11], v[36:39], v[144:147], v[8:11]
    v_cvt_pk_bf16_f32 v48, v59, v59
    v_and_b32 v32, v48, v4
    v_and_b32 v33, v48, v5
    v_and_b32 v34, v48, v6
    v_and_b32 v35, v48, v7
    s_waitcnt vmcnt(6)
    v_add_u32_dpp v45, v44, v1 row_newbcast:6 row_mask:0xf bank_mask:0xf
    buffer_load_dwordx4 v[88:91], v45, s[24:27], 0 offen offset:0 nt
    v_mfma_f32_16x16x32_bf16 v[12:15], v[36:39], v[148:151], v[12:15]
    s_waitcnt vmcnt(6)
    v_mfma_f32_16x16x32_bf16 v[8:11], v[32:35], v[152:155], v[8:11]
    v_cvt_pk_bf16_f32 v48, v60, v60
    v_and_b32 v36, v48, v4
    v_and_b32 v37, v48, v5
    v_and_b32 v38, v48, v6
    v_and_b32 v39, v48, v7
    s_waitcnt vmcnt(5)
    buffer_load_dwordx4 v[92:95], v45, s[24:27], 0 offen offset:256 nt
    v_mfma_f32_16x16x32_bf16 v[12:15], v[32:35], v[156:159], v[12:15]
    s_waitcnt vmcnt(5)
    v_add_u32_dpp v45, v44, v1 row_newbcast:7 row_mask:0xf bank_mask:0xf
    buffer_load_dwordx4 v[96:99], v45, s[24:27], 0 offen offset:0 nt
    v_mfma_f32_16x16x32_bf16 v[8:11], v[36:39], v[160:163], v[8:11]
    v_cvt_pk_bf16_f32 v48, v61, v61
    v_and_b32 v32, v48, v4
    v_and_b32 v33, v48, v5
    v_and_b32 v34, v48, v6
    v_and_b32 v35, v48, v7
    s_waitcnt vmcnt(5)
    buffer_load_dwordx4 v[100:103], v45, s[24:27], 0 offen offset:256 nt
    v_mfma_f32_16x16x32_bf16 v[12:15], v[36:39], v[164:167], v[12:15]
    s_waitcnt vmcnt(5)
    v_add_u32_dpp v45, v44, v1 row_newbcast:8 row_mask:0xf bank_mask:0xf
    buffer_load_dwordx4 v[104:107], v45, s[24:27], 0 offen offset:0 nt
    v_mfma_f32_16x16x32_bf16 v[8:11], v[32:35], v[80:83], v[8:11]
    v_cvt_pk_bf16_f32 v48, v62, v62
    v_and_b32 v36, v48, v4
    v_and_b32 v37, v48, v5
    v_and_b32 v38, v48, v6
    v_and_b32 v39, v48, v7
    s_waitcnt vmcnt(5)
    buffer_load_dwordx4 v[108:111], v45, s[24:27], 0 offen offset:256 nt
    v_mfma_f32_16x16x32_bf16 v[12:15], v[32:35], v[84:87], v[12:15]
    s_waitcnt vmcnt(5)
    v_add_u32_dpp v45, v44, v1 row_newbcast:9 row_mask:0xf bank_mask:0xf
    buffer_load_dwordx4 v[112:115], v45, s[24:27], 0 offen offset:0 nt
    v_mfma_f32_16x16x32_bf16 v[8:11], v[36:39], v[88:91], v[8:11]
    v_cvt_pk_bf16_f32 v48, v63, v63
    v_and_b32 v32, v48, v4
    v_and_b32 v33, v48, v5
    v_and_b32 v34, v48, v6
    v_and_b32 v35, v48, v7
    s_waitcnt vmcnt(5)
    buffer_load_dwordx4 v[116:119], v45, s[24:27], 0 offen offset:256 nt
    v_mfma_f32_16x16x32_bf16 v[12:15], v[36:39], v[92:95], v[12:15]
    s_waitcnt vmcnt(5)
    v_add_u32_dpp v45, v44, v1 row_newbcast:10 row_mask:0xf bank_mask:0xf
    buffer_load_dwordx4 v[120:123], v45, s[24:27], 0 offen offset:0 nt
    v_mfma_f32_16x16x32_bf16 v[8:11], v[32:35], v[96:99], v[8:11]
    v_cvt_pk_bf16_f32 v48, v64, v64
    v_and_b32 v36, v48, v4
    v_and_b32 v37, v48, v5
    v_and_b32 v38, v48, v6
    v_and_b32 v39, v48, v7
    s_waitcnt vmcnt(5)
    buffer_load_dwordx4 v[124:127], v45, s[24:27], 0 offen offset:256 nt
    v_mfma_f32_16x16x32_bf16 v[12:15], v[32:35], v[100:103], v[12:15]
    s_waitcnt vmcnt(5)
    v_add_u32_dpp v45, v44, v1 row_newbcast:11 row_mask:0xf bank_mask:0xf
    buffer_load_dwordx4 v[128:131], v45, s[24:27], 0 offen offset:0 nt
    v_mfma_f32_16x16x32_bf16 v[8:11], v[36:39], v[104:107], v[8:11]
    v_cvt_pk_bf16_f32 v48, v65, v65
    v_and_b32 v32, v48, v4
    v_and_b32 v33, v48, v5
    v_and_b32 v34, v48, v6
    v_and_b32 v35, v48, v7
    s_waitcnt vmcnt(5)
    buffer_load_dwordx4 v[132:135], v45, s[24:27], 0 offen offset:256 nt
    v_mfma_f32_16x16x32_bf16 v[12:15], v[36:39], v[108:111], v[12:15]
    s_waitcnt vmcnt(5)
    v_add_u32_dpp v45, v44, v1 row_newbcast:12 row_mask:0xf bank_mask:0xf
    buffer_load_dwordx4 v[136:139], v45, s[24:27], 0 offen offset:0 nt
    v_mov_b32 v55, 2
    s_mov_b64 exec, 1
    ds_write_b32 v46, v55 offset:192
    s_mov_b64 exec, -1
    v_mfma_f32_16x16x32_bf16 v[8:11], v[32:35], v[112:115], v[8:11]
    v_cvt_pk_bf16_f32 v48, v66, v66
    v_and_b32 v36, v48, v4
    v_and_b32 v37, v48, v5
    v_and_b32 v38, v48, v6
    v_and_b32 v39, v48, v7
    s_waitcnt vmcnt(5)
    buffer_load_dwordx4 v[140:143], v45, s[24:27], 0 offen offset:256 nt
    v_mfma_f32_16x16x32_bf16 v[12:15], v[32:35], v[116:119], v[12:15]
    s_waitcnt vmcnt(5)
    v_add_u32_dpp v45, v44, v1 row_newbcast:13 row_mask:0xf bank_mask:0xf
    buffer_load_dwordx4 v[144:147], v45, s[24:27], 0 offen offset:0
    v_mfma_f32_16x16x32_bf16 v[8:11], v[36:39], v[120:123], v[8:11]
    v_cvt_pk_bf16_f32 v48, v67, v67
    v_and_b32 v32, v48, v4
    v_and_b32 v33, v48, v5
    v_and_b32 v34, v48, v6
    v_and_b32 v35, v48, v7
    s_waitcnt vmcnt(5)
    buffer_load_dwordx4 v[148:151], v45, s[24:27], 0 offen offset:256
    v_mfma_f32_16x16x32_bf16 v[12:15], v[36:39], v[124:127], v[12:15]
    s_waitcnt vmcnt(5)
    v_add_u32_dpp v45, v44, v1 row_newbcast:14 row_mask:0xf bank_mask:0xf
    buffer_load_dwordx4 v[152:155], v45, s[24:27], 0 offen offset:0
    v_mfma_f32_16x16x32_bf16 v[8:11], v[32:35], v[128:131], v[8:11]
    v_cvt_pk_bf16_f32 v48, v68, v68
    v_and_b32 v36, v48, v4
    v_and_b32 v37, v48, v5
    v_and_b32 v38, v48, v6
    v_and_b32 v39, v48, v7
    s_waitcnt vmcnt(5)
    buffer_load_dwordx4 v[156:159], v45, s[24:27], 0 offen offset:256
    ds_bpermute_b32 v74, v72, v44 offset:52
    v_mfma_f32_16x16x32_bf16 v[12:15], v[32:35], v[132:135], v[12:15]
    s_waitcnt vmcnt(5)
    s_xor_b32 s66, s67, 0x4000
    s_waitcnt lgkmcnt(0)
    v_add3_u32 v74, v74, v73, s66
    s_mov_b32 exec_lo, 0xff00ff
    s_mov_b32 exec_hi, 0xff00ff
    buffer_load_dword v47, v74, s[24:27], 0 offen
    s_mov_b64 exec, -1
    v_mfma_f32_16x16x32_bf16 v[8:11], v[36:39], v[136:139], v[8:11]
    v_cvt_pk_bf16_f32 v48, v69, v69
    v_and_b32 v32, v48, v4
    v_and_b32 v33, v48, v5
    v_and_b32 v34, v48, v6
    v_and_b32 v35, v48, v7
    s_waitcnt vmcnt(5)
    v_mfma_f32_16x16x32_bf16 v[12:15], v[36:39], v[140:143], v[12:15]
    s_waitcnt vmcnt(4)
    v_mfma_f32_16x16x32_bf16 v[8:11], v[32:35], v[144:147], v[8:11]
    v_cvt_pk_bf16_f32 v48, v70, v70
    v_and_b32 v36, v48, v4
    v_and_b32 v37, v48, v5
    v_and_b32 v38, v48, v6
    v_and_b32 v39, v48, v7
    s_waitcnt vmcnt(3)
    v_mfma_f32_16x16x32_bf16 v[12:15], v[32:35], v[148:151], v[12:15]
    s_waitcnt vmcnt(2)
    v_mfma_f32_16x16x32_bf16 v[8:11], v[36:39], v[152:155], v[8:11]
    s_waitcnt vmcnt(1)
    v_mfma_f32_16x16x32_bf16 v[12:15], v[36:39], v[156:159], v[12:15]
    s_nop 5
    ds_write_b128 v43, v[8:11] offset:256
    s_nop 0
    ds_write_b128 v43, v[12:15] offset:1280
    s_waitcnt lgkmcnt(0)
    s_barrier
    ds_read_b32 v48, v76 offset:8512
    ds_read_b128 v[32:35], v77 offset:8448
    ds_read_b64 v[16:17], v75 offset:256
    ds_read_b64 v[18:19], v75 offset:2304
    ds_read_b64 v[20:21], v75 offset:4352
    ds_read_b64 v[22:23], v75 offset:6400
    s_waitcnt lgkmcnt(5)
    v_cmp_lt_u32 vcc, s44, v48
    s_waitcnt lgkmcnt(3)
    v_pk_mul_f32 v[16:17], v[32:33], v[16:17] op_sel:[0,0] op_sel_hi:[0,1]
    s_waitcnt lgkmcnt(2)
    v_pk_fma_f32 v[16:17], v[32:33], v[18:19], v[16:17] op_sel:[1,0,0] op_sel_hi:[1,1,1]
    s_waitcnt lgkmcnt(1)
    v_pk_fma_f32 v[16:17], v[34:35], v[20:21], v[16:17] op_sel:[0,0,0] op_sel_hi:[0,1,1]
    s_waitcnt lgkmcnt(0)
    v_pk_fma_f32 v[16:17], v[34:35], v[22:23], v[16:17] op_sel:[1,0,0] op_sel_hi:[1,1,1]
    v_bfi_b32 v16, s44, v48, v16
    v_bfi_b32 v17, s44, v48, v17
    s_cbranch_vccnz L_far
    global_store_dwordx2 v78, v[16:17], s[18:19]
    s_endpgm
L_far:
    global_store_dwordx2 v78, v[16:17], s[18:19] sc1
    s_endpgm
L_svc:
    s_load_dword s30, s[12:13], 0
    s_lshl_b32 s65, s29, 9
    s_add_u32 s65, s65, 0x80000
    v_and_b32 v1, 31, v0
    v_lshrrev_b32 v2, 5, v0
    v_lshl_add_u32 v16, v2, 3, s65
    v_lshl_add_u32 v17, v1, 4, v16
    s_lshl_b32 s66, s28, 4
    v_add_u32 v16, s66, v16
    v_lshlrev_b32 v21, 5, v2
    s_lshl_b32 s66, s29, 5
    v_mov_b32 v18, s66
    s_add_u32 s66, s66, s28
    s_lshl_b32 s66, s66, 11
    v_lshl_add_u32 v19, v0, 4, s66
    v_mov_b32 v12, -1
    v_mov_b32 v13, -1
    s_cmp_lg_u32 s28, 0
    s_cbranch_scc1 L_nolead
    global_store_dwordx2 v17, v[12:13], s[18:19] sc1
    s_waitcnt vmcnt(0)
    s_mov_b64 exec, 1
    global_store_dword v18, v12, s[16:17] sc1
    s_mov_b64 exec, -1
L_nolead:
    global_load_dwordx4 v[4:7], v19, s[18:19] sc1
    global_load_dwordx4 v[8:11], v19, s[18:19] offset:1024 sc1
    s_lshl_b32 s64, s29, 10
    s_and_b32 s65, s28, 11
    s_lshl_b32 s65, s65, 6
    s_add_u32 s64, s64, s65
    s_and_b32 s65, s28, 16
    s_lshl_b32 s65, s65, 4
    s_add_u32 s64, s64, s65
    s_and_b32 s65, s28, 4
    s_lshl_b32 s65, s65, 1
    s_add_u32 s64, s64, s65
    v_and_b32 v14, 3, v0
    v_lshl_add_u32 v20, v14, 4, s64
    v_bfe_u32 v14, v0, 4, 1
    v_lshl_add_u32 v20, v14, 2, v20
    v_lshl_add_u32 v20, v2, 1, v20
    v_mov_b32 v22, 0
    s_mov_b32 s40, 1
    s_mov_b32 s41, 1
    s_mov_b32 s42, 0x000f000f
    s_mov_b32 s43, 0x000f000f
    s_movk_i32 s44, 0x3ff
    s_getreg_b32 s69, hwreg(HW_REG_XCC_ID, 0, 4)
    s_waitcnt lgkmcnt(0)
    s_cmp_gt_i32 s30, 0
    s_cselect_b32 s36, 0x3db8aa3b, 0
    s_waitcnt vmcnt(0)
    v_and_b32 v4, s44, v4
    v_and_b32 v5, s44, v5
    v_and_b32 v6, s44, v6
    v_and_b32 v7, s44, v7
    v_and_b32 v8, s44, v8
    v_and_b32 v9, s44, v9
    v_and_b32 v10, s44, v10
    v_and_b32 v11, s44, v11
    s_mov_b32 s68, -1
L_tag:
    s_add_u32 s68, s68, 1
    v_xor_b32 v36, s68, v4
    v_xor_b32 v37, s68, v5
    v_xor_b32 v38, s68, v6
    v_xor_b32 v39, s68, v7
    v_xor_b32 v40, s68, v8
    v_xor_b32 v41, s68, v9
    v_xor_b32 v42, s68, v10
    v_xor_b32 v43, s68, v11
    v_min3_u32 v1, v36, v37, v38
    v_min3_u32 v1, v1, v39, v40
    v_min3_u32 v1, v1, v41, v42
    v_min_u32 v1, v1, v43
    v_cmp_eq_u32 vcc, 0, v1
    s_cbranch_vccnz L_tag
    s_mov_b32 s65, 0x40000
L_p1:
    ds_read_b32 v1, v22 offset:192
    s_sub_u32 s65, s65, 1
    s_waitcnt lgkmcnt(0)
    v_cmp_gt_i32 vcc, 1, v1
    s_cbranch_scc1 L_p1x
    s_cbranch_vccnz L_p1
L_p1x:
    s_mov_b32 s65, 0x40000
L_flag:
    global_load_dword v1, v18, s[16:17] sc1
    s_sub_u32 s65, s65, 1
    s_waitcnt vmcnt(0)
    v_cmp_eq_u32 vcc, 0, v1
    s_cbranch_scc1 L_flagx
    s_cbranch_vccnz L_flag
L_flagx:
    s_mov_b32 s65, 0x40000
L_ml:
    ds_read_b128 v[28:31], v21 offset:0
    ds_read_b128 v[32:35], v21 offset:16
    s_sub_u32 s65, s65, 1
    s_waitcnt lgkmcnt(0)
    v_max_u32 v1, v28, v29
    v_max3_u32 v1, v1, v30, v31
    v_max3_u32 v1, v1, v32, v33
    v_max3_u32 v1, v1, v34, v35
    v_cmp_eq_u32 vcc, -1, v1
    s_cbranch_scc1 L_mlx
    s_cbranch_vccnz L_ml
L_mlx:
    v_max_f32 v2, v28, v29
    v_max3_f32 v2, v2, v30, v31
    v_sub_f32 v24, v28, v2
    v_sub_f32 v25, v29, v2
    v_sub_f32 v26, v30, v2
    v_sub_f32 v27, v31, v2
    v_mul_f32 v24, s36, v24
    v_mul_f32 v25, s36, v25
    v_mul_f32 v26, s36, v26
    v_mul_f32 v27, s36, v27
    v_exp_f32 v24, v24
    v_exp_f32 v25, v25
    v_exp_f32 v26, v26
    v_exp_f32 v27, v27
    s_lshl_b32 s66, s69, 12
    s_or_b32 s66, s66, s68
    v_or_b32 v2, s66, v2
    v_mul_f32 v3, v24, v32
    v_fmac_f32 v3, v25, v33
    v_fmac_f32 v3, v26, v34
    v_fmac_f32 v3, v27, v35
    s_mov_b64 exec, s[40:41]
    global_store_dwordx2 v16, v[2:3], s[18:19] sc1
    s_mov_b64 exec, -1
    s_mov_b32 s65, 0x40000
L_p2:
    ds_read_b32 v1, v22 offset:192
    s_sub_u32 s65, s65, 1
    s_waitcnt lgkmcnt(0)
    v_cmp_gt_i32 vcc, 2, v1
    s_cbranch_scc1 L_p2x
    s_cbranch_vccnz L_p2
L_p2x:
    s_mov_b32 s65, 0x40000
L_rec:
    global_load_dwordx2 v[2:3], v17, s[18:19] sc1
    s_sub_u32 s65, s65, 1
    s_waitcnt vmcnt(0)
    v_max_u32 v1, v2, v3
    v_cmp_eq_u32 vcc, -1, v1
    s_cbranch_scc1 L_recx
    s_cbranch_vccnz L_rec
L_recx:
    v_bfe_u32 v1, v2, 12, 4
    v_cmp_ne_u32 vcc, s69, v1
    v_and_b32 v4, s44, v2
    v_lshlrev_b32 v1, 2, v0
    s_cmp_lg_u64 vcc, 0
    s_cselect_b32 s66, 0x400, 0
    v_or_b32 v4, s66, v4
    s_mov_b32 exec_hi, 0
    ds_write_b32 v1, v4 offset:8512
    s_mov_b32 exec_hi, -1
    v_and_b32 v6, 0xffff0000, v2
    v_mov_b32 v7, v6
    s_nop 1
    v_max_f32_dpp v7, v7, v7 row_ror:1 row_mask:0xf bank_mask:0xf
    s_nop 1
    v_max_f32_dpp v7, v7, v7 row_ror:2 row_mask:0xf bank_mask:0xf
    s_nop 1
    v_max_f32_dpp v7, v7, v7 row_ror:4 row_mask:0xf bank_mask:0xf
    s_nop 1
    v_max_f32_dpp v7, v7, v7 row_ror:8 row_mask:0xf bank_mask:0xf
    v_mov_b32 v5, v7
    s_nop 1
    v_permlane16_swap_b32 v5, v7
    v_max_f32 v7, v7, v5
    v_sub_f32 v6, v6, v7
    v_mul_f32 v6, s36, v6
    v_exp_f32 v6, v6
    v_sub_f32 v24, v28, v7
    v_sub_f32 v25, v29, v7
    v_sub_f32 v26, v30, v7
    v_sub_f32 v27, v31, v7
    v_mul_f32 v24, s36, v24
    v_mul_f32 v25, s36, v25
    v_mul_f32 v26, s36, v26
    v_mul_f32 v27, s36, v27
    v_mul_f32 v3, v6, v3
    s_nop 1
    v_add_f32_dpp v3, v3, v3 row_ror:1 row_mask:0xf bank_mask:0xf
    s_nop 1
    v_add_f32_dpp v3, v3, v3 row_ror:2 row_mask:0xf bank_mask:0xf
    s_nop 1
    v_add_f32_dpp v3, v3, v3 row_ror:4 row_mask:0xf bank_mask:0xf
    s_nop 1
    v_add_f32_dpp v3, v3, v3 row_ror:8 row_mask:0xf bank_mask:0xf
    v_mov_b32 v5, v3
    s_nop 1
    v_permlane16_swap_b32 v5, v3
    v_add_f32 v3, v3, v5
    v_rcp_f32 v3, v3
    v_exp_f32 v24, v24
    v_exp_f32 v25, v25
    v_exp_f32 v26, v26
    v_exp_f32 v27, v27
    v_lshrrev_b32 v1, 1, v0
    v_mul_f32 v24, v24, v3
    v_mul_f32 v25, v25, v3
    v_mul_f32 v26, v26, v3
    v_mul_f32 v27, v27, v3
    s_mov_b64 exec, s[40:41]
    ds_write_b128 v1, v[24:27] offset:8448
    s_mov_b64 exec, -1
    s_mov_b32 s65, 0x40000
    s_waitcnt lgkmcnt(0)
    s_barrier
    global_load_dwordx4 v[44:47], v19, s[18:19] sc1
    global_load_dwordx4 v[48:51], v19, s[18:19] offset:1024 sc1
    global_load_dwordx4 v[52:55], v19, s[18:19] sc1
    global_load_dwordx4 v[56:59], v19, s[18:19] offset:1024 sc1
L_poll:
    global_load_dwordx4 v[60:63], v19, s[18:19] sc1
    global_load_dwordx4 v[64:67], v19, s[18:19] offset:1024 sc1
    s_waitcnt vmcnt(5)
    v_xor_b32 v4, s68, v44
    v_xor_b32 v5, s68, v45
    v_xor_b32 v6, s68, v46
    v_xor_b32 v7, s68, v47
    v_or3_b32 v1, v4, v5, v6
    s_waitcnt vmcnt(4)
    v_xor_b32 v8, s68, v48
    v_xor_b32 v9, s68, v49
    v_xor_b32 v10, s68, v50
    v_xor_b32 v11, s68, v51
    v_or3_b32 v2, v7, v8, v9
    v_or3_b32 v1, v1, v10, v11
    v_bitop3_b32 v1, v1, v2, s44 bitop3:0xa8
    v_cmp_ne_u32 vcc, 0, v1
    v_pk_add_f32 v[4:5], v[4:5], v[8:9]
    v_pk_add_f32 v[6:7], v[6:7], v[10:11]
    s_cbranch_vccz L_pollx
    global_load_dwordx4 v[44:47], v19, s[18:19] sc1
    global_load_dwordx4 v[48:51], v19, s[18:19] offset:1024 sc1
    s_waitcnt vmcnt(5)
    v_xor_b32 v4, s68, v52
    v_xor_b32 v5, s68, v53
    v_xor_b32 v6, s68, v54
    v_xor_b32 v7, s68, v55
    v_or3_b32 v1, v4, v5, v6
    s_waitcnt vmcnt(4)
    v_xor_b32 v8, s68, v56
    v_xor_b32 v9, s68, v57
    v_xor_b32 v10, s68, v58
    v_xor_b32 v11, s68, v59
    v_or3_b32 v2, v7, v8, v9
    v_or3_b32 v1, v1, v10, v11
    v_bitop3_b32 v1, v1, v2, s44 bitop3:0xa8
    v_cmp_ne_u32 vcc, 0, v1
    v_pk_add_f32 v[4:5], v[4:5], v[8:9]
    v_pk_add_f32 v[6:7], v[6:7], v[10:11]
    s_cbranch_vccz L_pollx
    global_load_dwordx4 v[52:55], v19, s[18:19] sc1
    global_load_dwordx4 v[56:59], v19, s[18:19] offset:1024 sc1
    s_waitcnt vmcnt(5)
    v_xor_b32 v4, s68, v60
    v_xor_b32 v5, s68, v61
    v_xor_b32 v6, s68, v62
    v_xor_b32 v7, s68, v63
    v_or3_b32 v1, v4, v5, v6
    s_waitcnt vmcnt(4)
    v_xor_b32 v8, s68, v64
    v_xor_b32 v9, s68, v65
    v_xor_b32 v10, s68, v66
    v_xor_b32 v11, s68, v67
    v_or3_b32 v2, v7, v8, v9
    v_or3_b32 v1, v1, v10, v11
    v_bitop3_b32 v1, v1, v2, s44 bitop3:0xa8
    v_cmp_ne_u32 vcc, 0, v1
    v_pk_add_f32 v[4:5], v[4:5], v[8:9]
    v_pk_add_f32 v[6:7], v[6:7], v[10:11]
    s_cbranch_vccz L_pollx
    s_sub_u32 s65, s65, 1
    s_cbranch_scc0 L_poll
L_pollx:
    v_permlane32_swap_b32 v4, v5
    v_permlane32_swap_b32 v6, v7
    v_add_f32 v4, v4, v5
    v_add_f32 v6, v6, v7
    s_nop 1
    v_permlane16_swap_b32 v4, v6
    v_add_f32 v4, v4, v6
    s_nop 1
    v_add_f32_dpp v4, v4, v4 row_ror:4 row_mask:0xf bank_mask:0xf
    s_nop 1
    v_add_f32_dpp v4, v4, v4 row_ror:8 row_mask:0xf bank_mask:0xf
    v_cvt_pk_bf16_f32 v4, v4, v4
    s_mov_b64 exec, s[42:43]
    global_store_short v20, v4, s[14:15]
L_done:
    s_endpgm
.section .rodata,"a"
.p2align 6
.amdhsa_kernel standalone__paged_block_table_kv_radixattention__decode_kernel
  .amdhsa_next_free_vgpr 168
  .amdhsa_next_free_sgpr 72
  .amdhsa_accum_offset 168
  .amdhsa_group_segment_fixed_size 0
  .amdhsa_kernarg_size 64
  .amdhsa_user_sgpr_count 2
  .amdhsa_user_sgpr_kernarg_segment_ptr 1
  .amdhsa_system_sgpr_workgroup_id_x 1
  .amdhsa_float_denorm_mode_32 3
.end_amdhsa_kernel
```
